```python
import torch

def _softmax(x, axis=-1):
    return torch.softmax(x, dim=axis)

def _gelu(x):
    return torch.nn.functional.gelu(x, approximate='tanh')

def _silu(x):
    return torch.nn.functional.silu(x)

def _sigmoid(x):
    return torch.sigmoid(x)

def _layernorm(x, axis=-1, eps=1e-05):
    m = x.mean(dim=axis, keepdim=True)
    v = x.var(dim=axis, keepdim=True, unbiased=False)
    return (x - m) / torch.sqrt(v + eps)

def _scatter_add(tgt, idx, src, axis=0):
    return tgt.clone().index_add_(axis, idx, src)

def _segment_sum(src, seg, n):
    out = torch.zeros((n,) + src.shape[1:], dtype=src.dtype)
    return out.index_add_(0, seg, src)

def _pad(x, pw):
    flat = tuple((v for pair in reversed(pw) for v in pair))
    return torch.nn.functional.pad(x, flat)
kernel_name = 'gather_scatter__tensor_product_equiv_mace__graph'

def setup_inputs():

    _w = lambda a: (lambda t: t.to(torch.bfloat16) if t.is_floating_point() else t)(torch.as_tensor(a))
    N, deg = (10000, 64)
    Lmax, C, De = (1, 64, 4)
    M = (Lmax + 1) ** 2
    E = N * deg
    src = (lambda lo, hi, *s: torch.randint(lo, hi, s))(0, N, E).to(torch.int64)
    dst = (lambda lo, hi, *s: torch.randint(lo, hi, s))(0, N, E).to(torch.int64)
    r = (lambda *s: torch.randn(*s, dtype=torch.bfloat16) * 0.05)(E, 3).to(float)
    r = r / (torch.linalg.norm(r, dim=-1, keepdim=True).to(float) + 1e-06)
    rx, ry, rz = (r[:, 0].clone(), r[:, 1].clone(), r[:, 2].clone())
    x2, y2, z2 = (rx * rx, ry * ry, rz * rz)
    sh_list = [torch.ones_like(rx), rx, ry, rz, rx * ry, ry * rz, 2.0 * z2 - x2 - y2, rx * rz, x2 - y2, ry * (3.0 * x2 - y2), rx * ry * rz, ry * (4.0 * z2 - x2 - y2), rz * (2.0 * z2 - 3.0 * x2 - 3.0 * y2), rx * (4.0 * z2 - x2 - y2), rz * (x2 - y2), rx * (x2 - 3.0 * y2)]
    sh16 = torch.stack(sh_list, dim=-1).to(float)
    pad = max(0, M - 16)
    sh_full = torch.cat([sh16, torch.zeros((E, pad), dtype=float)], dim=-1)[:, :M]
    cg = ((lambda *s: torch.randn(*s, dtype=torch.bfloat16) * 0.05)(M, M, M) * (1.0 / float(M))).to(float)
    return {'x': _w(((lambda *s: torch.randn(*s, dtype=torch.bfloat16) * 0.05)(N, M, C) * 0.3).to(float)), 'src': _w(src), 'dst': _w(dst), 'sh': _w(sh_full.to(float)), 'edge_attr': _w(((lambda *s: torch.randn(*s, dtype=torch.bfloat16) * 0.05)(E, De) * 0.3).to(float)), 'cg': _w(cg), 'w_r': _w(((lambda *s: torch.randn(*s, dtype=torch.bfloat16) * 0.05)(De, C) * (1.0 / float(De) ** 0.5)).to(float)), 'w_out': _w(((lambda *s: torch.randn(*s, dtype=torch.bfloat16) * 0.05)(C, C) * (1.0 / float(C) ** 0.5)).to(float))}

def reference(x, src, dst, sh, edge_attr, cg, w_r, w_out):
    N = x.shape[0]
    M = x.shape[1]
    C = x.shape[2]
    h = x[src]
    tp = torch.einsum('uvw,euc,ev->ewc', cg, h, sh)
    rw = edge_attr @ w_r
    msg = tp * rw[:, None, :]
    msg2 = msg.reshape(-1, M * C)
    agg = _segment_sum(msg2, dst, N).reshape(N, M, C)
    out = torch.einsum('nmc,cd->nmd', agg, w_out)
    return out
```

```asm
; @launch grid=(256,1,1) block=(512,1,1) lds=130560
.amdgcn_target "amdgcn-amd-amdhsa--gfx950"
.text
.globl gather_scatter__tensor_product_equiv_mace__graph_kernel
.type gather_scatter__tensor_product_equiv_mace__graph_kernel,@function
.p2align 8
gather_scatter__tensor_product_equiv_mace__graph_kernel:
    s_load_dwordx16 s[4:19], s[0:1], 0
    s_getpc_b64 s[54:55]
K_PC0:
    v_lshlrev_b32 v1, 7, v0
    v_min_u32 v1, K_TABEND-K_PC0-4, v1
    global_load_dword v77, v1, s[54:55]
    s_load_dwordx4 s[20:23], s[0:1], 64
    s_load_dwordx2 s[24:25], s[0:1], 80
    s_cmpk_ge_u32 s2, 256
    s_cbranch_scc1 K_END
    v_lshrrev_b32 v54, 6, v0
    s_mul_i32 s3, s2, 625
    v_readfirstlane_b32 s26, v54
    s_add_u32 s54, s3, 625
    s_lshr_b32 s3, s3, 2
    s_lshr_b32 s54, s54, 2
    s_sub_u32 s54, s54, s3
    s_lshl_b32 s54, s54, 4
    s_sub_u32 s54, s54, 2049
    s_lshl_b32 s3, s3, 6
    s_addk_i32 s3, 4096
    v_lshl_add_u32 v1, v0, 3, s3
    v_min_u32 v2, s54, v0
    s_addk_i32 s3, 4096
    v_lshl_add_u32 v2, v2, 2, s3
    v_lshlrev_b32 v54, 2, v0
    v_mov_b32 v55, 0
    ds_write_b32 v54, v55
    v_cmp_ge_u32 s[62:63], s54, v0
    v_lshlrev_b32 v3, 1, v1
    v_lshlrev_b32 v57, 1, v2
    v_add_u32 v56, 0xffffe000, v3
    s_or_b32 s55, s2, s26
    s_waitcnt lgkmcnt(0)
    s_cbranch_scc1 K1_NOZ
    global_load_dword v71, v55, s[24:25] sc1
K1_NOZ:
    global_load_dwordx2 v[4:5], v1, s[8:9] offset:-4096
    global_load_dwordx2 v[6:7], v1, s[8:9]
    global_load_dword v8, v2, s[8:9]
    global_load_dwordx2 v[10:11], v1, s[6:7] offset:-4096
    global_load_dwordx2 v[12:13], v1, s[6:7]
    global_load_dword v14, v2, s[6:7]
    s_mov_b32 s50, 429497
    s_movk_i32 s51, 625
    v_mov_b32 v53, 1
    s_barrier
    global_load_dwordx4 v[16:19], v56, s[10:11]
    global_load_dwordx4 v[20:23], v3, s[10:11]
    global_load_dwordx2 v[24:25], v57, s[10:11]
    global_load_dwordx4 v[26:29], v56, s[12:13]
    global_load_dwordx4 v[30:33], v3, s[12:13]
    global_load_dwordx2 v[34:35], v57, s[12:13]
    v_and_b32 v159, 63, v0
    v_lshlrev_b32 v58, 4, v159
    s_cmp_lg_u32 s55, 0
    s_waitcnt vmcnt(9)
    s_cbranch_scc1 K1_NOZ2
    v_readfirstlane_b32 s3, v71
    s_mul_i32 s54, s3, 0x9e3779b1
    s_add_u32 s54, s54, 0x7f4a7c15
    s_or_b32 s54, s54, 1
    s_cmp_eq_u32 s54, s3
    s_cselect_b32 s3, 2, 0
    s_xor_b32 s54, s54, s3
    v_mov_b32 v71, s54
    s_mov_b64 exec, 1
    global_store_dword v55, v71, s[22:23] sc1
    s_mov_b64 exec, -1
K1_NOZ2:
    v_mul_u32_u24 v36, s50, v4
    v_mul_u32_u24 v37, s50, v5
    v_mul_u32_u24 v38, s50, v6
    v_mul_u32_u24 v39, s50, v7
    v_mul_u32_u24 v40, s50, v8
    v_lshrrev_b32 v48, 24, v36
    v_lshrrev_b32 v49, 24, v37
    v_lshrrev_b32 v50, 24, v38
    v_lshrrev_b32 v51, 24, v39
    v_lshrrev_b32 v52, 24, v40
    v_lshlrev_b32 v36, 2, v48
    ds_add_rtn_u32 v42, v36, v53 offset:0
    v_lshlrev_b32 v37, 2, v49
    ds_add_rtn_u32 v43, v37, v53 offset:0
    v_lshlrev_b32 v38, 2, v50
    ds_add_rtn_u32 v44, v38, v53 offset:0
    v_lshlrev_b32 v39, 2, v51
    ds_add_rtn_u32 v45, v39, v53 offset:0
    v_lshlrev_b32 v40, 2, v52
    s_mov_b64 exec, s[62:63]
    ds_add_rtn_u32 v46, v40, v53 offset:0
    s_mov_b64 exec, -1
    s_waitcnt lgkmcnt(0)
    s_barrier
    ds_read_b128 v[60:63], v58 offset:0
    v_mad_u32_u24 v48, v48, s51, 15
    v_mad_u32_u24 v49, v49, s51, 15
    v_mad_u32_u24 v50, v50, s51, 15
    s_waitcnt lgkmcnt(0)
    v_add_u32 v66, v60, v61
    v_add_u32 v67, v66, v62
    v_add_u32 v68, v67, v63
    v_mov_b32 v63, v68
    v_mad_u32_u24 v51, v51, s51, 15
    v_mad_u32_u24 v52, v52, s51, 15
    v_add_u32_dpp v63, v63, v63 row_shr:1 row_mask:0xf bank_mask:0xf bound_ctrl:0
    v_lshrrev_b32 v48, 4, v48
    v_lshrrev_b32 v49, 4, v49
    v_add_u32_dpp v63, v63, v63 row_shr:2 row_mask:0xf bank_mask:0xf bound_ctrl:0
    v_lshrrev_b32 v50, 4, v50
    v_lshrrev_b32 v51, 4, v51
    v_add_u32_dpp v63, v63, v63 row_shr:4 row_mask:0xf bank_mask:0xf bound_ctrl:0
    v_lshrrev_b32 v52, 4, v52
    v_sub_u32 v4, v4, v48
    v_add_u32_dpp v63, v63, v63 row_shr:8 row_mask:0xf bank_mask:0xf bound_ctrl:0
    v_sub_u32 v5, v5, v49
    v_sub_u32 v6, v6, v50
    v_add_u32_dpp v63, v63, v63 row_bcast:15 row_mask:0xa bank_mask:0xf
    v_sub_u32 v7, v7, v51
    v_sub_u32 v8, v8, v52
    v_add_u32_dpp v63, v63, v63 row_bcast:31 row_mask:0xc bank_mask:0xf
    v_sub_u32 v64, v63, v68
    v_add_u32 v65, v64, v60
    v_add_u32 v66, v64, v66
    v_add_u32 v67, v64, v67
    ds_write_b128 v58, v[64:67] offset:1024
    ds_read_b32 v48, v36 offset:1024
    ds_read_b32 v49, v37 offset:1024
    ds_read_b32 v50, v38 offset:1024
    ds_read_b32 v51, v39 offset:1024
    ds_read_b32 v52, v40 offset:1024
    v_lshl_or_b32 v61, v65, 16, v64
    v_lshl_or_b32 v62, v67, 16, v66
    s_lshl_b32 s3, s2, 10
    v_add_u32 v59, s3, v58
    s_waitcnt vmcnt(6)
    v_lshl_or_b32 v4, v10, 7, v4
    v_lshl_or_b32 v5, v11, 7, v5
    v_lshl_or_b32 v6, v12, 7, v6
    v_lshl_or_b32 v7, v13, 7, v7
    v_lshl_or_b32 v8, v14, 7, v8
    v_lshlrev_b32 v4, 2, v4
    v_lshlrev_b32 v5, 2, v5
    v_lshlrev_b32 v6, 2, v6
    v_lshlrev_b32 v7, 2, v7
    v_lshlrev_b32 v8, 2, v8
    s_waitcnt lgkmcnt(0)
    v_add_lshl_u32 v36, v48, v42, 2
    ds_write_b32 v36, v4 offset:2048
    v_add_lshl_u32 v37, v49, v43, 2
    ds_write_b32 v37, v5 offset:2048
    v_add_lshl_u32 v38, v50, v44, 2
    ds_write_b32 v38, v6 offset:2048
    v_add_lshl_u32 v39, v51, v45, 2
    ds_write_b32 v39, v7 offset:2048
    v_add_lshl_u32 v40, v52, v46, 2
    s_mov_b64 exec, s[62:63]
    ds_write_b32 v40, v8 offset:2048
    s_mov_b64 exec, -1
    v_lshlrev_b32 v10, 2, v36
    v_lshlrev_b32 v11, 2, v37
    v_lshlrev_b32 v12, 2, v38
    v_lshlrev_b32 v13, 2, v39
    v_lshlrev_b32 v14, 2, v40
    v_lshlrev_b32 v1, 4, v0
    s_mul_i32 s3, s2, 10240
    s_add_u32 s3, s3, 524288
    v_add_u32 v2, s3, v1
    s_addk_i32 s3, 8192
    v_add_u32 v3, s3, v54
    v_cmp_gt_u32 vcc, 480, v0
    s_mov_b64 s[64:65], vcc
    s_mul_i32 s3, s2, 40960
    s_add_u32 s3, s3, 3145728
    v_add_u32 v42, s3, v1
    v_add_u32 v43, 8192, v42
    v_add_u32 v44, 16384, v42
    v_add_u32 v45, 24576, v42
    v_add_u32 v46, 32768, v42
    s_and_b32 s29, s2, 7
    s_lshl_b32 s29, s29, 5
    s_lshr_b32 s3, s2, 3
    s_add_u32 s29, s29, s3
    s_mul_i32 s30, s29, 625
    s_add_u32 s31, s30, 640
    s_add_u32 s30, s30, 15
    s_lshr_b32 s30, s30, 4
    s_lshr_b32 s31, s31, 4
    s_sub_u32 s31, s31, s30
    s_getpc_b64 s[54:55]
K2_PC:
    s_lshl_b32 s3, s31, 6
    s_add_u32 s3, s3, K_RANKTAB-K2_PC-2496
    v_add_u32 v170, s3, v159
    global_load_ubyte v170, v170, s[54:55]
    v_bfe_u32 v75, v0, 2, 2
    v_and_b32 v76, 3, v0
    v_lshlrev_b32 v77, 5, v76
    v_lshl_add_u32 v77, v75, 1, v77
    s_mul_i32 s3, s26, 1056
    s_add_u32 m0, s3, 66560
    global_load_ushort v148, v77, s[14:15] offset:0
    global_load_ushort v149, v77, s[14:15] offset:8
    global_load_ushort v150, v77, s[14:15] offset:16
    global_load_ushort v151, v77, s[14:15] offset:24
    global_load_dwordx4 v[98:101], v1, s[18:19]
    s_cmp_lg_u32 s26, 0
    s_cbranch_scc1 K1_NOWR
    s_mov_b64 exec, 0xffffffff
    global_load_dwordx4 v[102:105], v1, s[16:17]
    s_mov_b64 exec, -1
K1_NOWR:
    s_waitcnt vmcnt(9)
    ds_write_b64 v10, v[16:17] offset:12288
    ds_write_b64 v11, v[18:19] offset:12288
    ds_write_b64 v12, v[20:21] offset:12288
    ds_write_b64 v13, v[22:23] offset:12288
    s_mov_b64 exec, s[62:63]
    ds_write_b64 v14, v[24:25] offset:12288
    s_mov_b64 exec, -1
    s_waitcnt vmcnt(8)
    ds_write_b64 v10, v[26:27] offset:12296
    ds_write_b64 v11, v[28:29] offset:12296
    s_waitcnt vmcnt(7)
    ds_write_b64 v12, v[30:31] offset:12296
    ds_write_b64 v13, v[32:33] offset:12296
    s_waitcnt vmcnt(6)
    s_mov_b64 exec, s[62:63]
    ds_write_b64 v14, v[34:35] offset:12296
    s_mov_b64 exec, -1
    s_mov_b32 s28, 0x200000
    s_waitcnt lgkmcnt(0)
    s_barrier
    global_load_dword v60, v55, s[22:23] sc1
    ds_read_b128 v[4:7], v1 offset:12288
    ds_read_b128 v[8:11], v1 offset:20480
    ds_read_b128 v[12:15], v1 offset:28672
    ds_read_b128 v[16:19], v1 offset:36864
    ds_read_b128 v[20:23], v1 offset:45056
    ds_read_b128 v[64:67], v1 offset:2048
    ds_read_b32 v68, v54 offset:10240
    s_waitcnt lgkmcnt(6)
    global_store_dwordx4 v42, v[4:7], s[24:25] sc1
    s_waitcnt lgkmcnt(5)
    s_waitcnt vmcnt(0)
    global_store_dwordx4 v43, v[8:11], s[24:25] sc1
    s_waitcnt lgkmcnt(4)
    global_store_dwordx4 v44, v[12:15], s[24:25] sc1
    s_waitcnt lgkmcnt(3)
    global_store_dwordx4 v45, v[16:19], s[24:25] sc1
    s_waitcnt lgkmcnt(2)
    s_mov_b64 exec, s[62:63]
    global_store_dwordx4 v46, v[20:23], s[24:25] sc1
    s_mov_b64 exec, -1
    s_waitcnt lgkmcnt(1)
    global_store_dwordx4 v2, v[64:67], s[24:25] sc1
    s_mov_b64 exec, s[64:65]
    s_waitcnt lgkmcnt(0)
    global_store_dword v3, v68, s[24:25] sc1
    s_mov_b64 exec, -1
    v_add_u32 v1, m0, v58
    ds_write_b128 v1, v[98:101]
    s_cmp_lg_u32 s26, 0
    s_cbranch_scc1 K1_NOWR2
    s_mov_b64 exec, 0xffffffff
    ds_write_b128 v1, v[102:105] offset:8448
    s_mov_b64 exec, -1
K1_NOWR2:
    s_mov_b32 s58, 0
    s_mov_b32 s59, 0
    s_mov_b32 s60, 0
    s_movk_i32 s48, 255
    v_lshrrev_b32 v74, 4, v159
    s_mul_i32 s56, s26, 8320
    v_lshlrev_b64 v[172:173], v159, -1
    v_not_b32 v172, v172
    v_not_b32 v173, v173
    v_and_b32 v174, 7, v159
    v_cmp_lt_u32 vcc, 0, v174
    v_cmp_lt_u32 s[88:89], 1, v174
    s_mov_b32 s47, 4294780416
    v_cndmask_b32 v171, 0, -1, vcc
    v_cndmask_b32 v174, 0, -1, s[88:89]
    v_lshlrev_b32 v160, 7, v75
    v_lshl_add_u32 v160, v76, 4, v160
    v_and_b32 v161, 1, v74
    v_lshl_add_u32 v160, v161, 6, v160
    v_add_u32 v161, 1, v74
    v_lshrrev_b32 v161, 1, v161
    v_lshlrev_b32 v161, 5, v161
    v_lshl_add_u32 v161, v74, 10, v161
    v_lshl_add_u32 v161, v75, 6, v161
    v_lshl_add_u32 v161, v76, 3, v161
    v_lshl_add_u32 v164, v74, 4, s47
    v_lshl_add_u32 v165, v76, 1, v164
    v_and_b32 v1, 1, v159
    v_lshl_add_u32 v164, v1, 6, v164
    v_mov_b32 v169, 128
    v_cmp_eq_u32 vcc, v75, v74
    v_lshlrev_b32 v1, 4, v76
    v_mov_b32 v162, 0x3f80
    v_mov_b32 v163, 0
    v_cndmask_b32_e64 v162, 0, v162, vcc
    v_lshlrev_b64 v[162:163], v1, v[162:163]
    v_lshlrev_b32 v1, 2, v74
    v_sub_u32 v167, 32, v1
    v_sub_u32 v168, 16, v1
    v_lshrrev_b32 v166, 5, v159
    v_lshlrev_b32 v166, 4, v166
    s_movk_i32 s44, 3136
    s_movk_i32 s45, 2080
    s_movk_i32 s46, 1056
    s_add_u32 s57, s56, 4160
    s_xor_b32 s57, s57, s56
    s_add_u32 s32, s24, 524288
    s_addc_u32 s33, s25, 262144
    s_mov_b32 s34, 655360
    s_mov_b32 s35, 0x20000
    s_add_u32 s36, s24, 3145728
    s_addc_u32 s37, s25, 1048576
    s_mov_b32 s38, 655360
    s_mov_b32 s39, 0x20000
    s_sub_u32 s40, s4, 3136
    s_subb_u32 s41, s5, 0
    s_mov_b32 s42, 5123136
    s_mov_b32 s43, 0x20000
    v_mov_b32 v82, 0
    v_mov_b32 v83, 0
    v_mov_b32 v84, 0
    v_mov_b32 v85, 0
    s_nop 1
    v_mfma_f32_32x32x16_bf16 v[176:191], v[82:85], v[82:85], 0
    v_mfma_f32_32x32x16_bf16 v[192:207], v[82:85], v[82:85], 0
    v_mfma_f32_32x32x16_bf16 v[208:223], v[82:85], v[82:85], 0
    v_mfma_f32_32x32x16_bf16 v[224:239], v[82:85], v[82:85], 0
    v_mfma_f32_32x32x16_bf16 v[240:255], v[82:85], v[82:85], 0
K2_BATCH:
    v_and_b32 v1, 31, v0
    s_lshl_b32 s3, s26, 8
    s_and_b32 s54, s29, 0xfc
    s_add_u32 s3, s3, s54
    s_lshl_b32 s3, s3, 2
    v_lshl_add_u32 v80, v1, 13, s3
    v_lshlrev_b32 v81, 5, v74
    v_mov_b32 v78, 0
    v_lshlrev_b32 v79, 2, v0
    ds_write_b32 v79, v78
    v_lshlrev_b32 v79, 2, v159
    ds_write_b32 v79, v78 offset:65280
    v_and_b32 v93, 15, v0
    s_lshl_b32 s54, s59, 4
    v_lshl_add_u32 v1, v74, 6, s26
    v_mul_u32_u24 v2, 2560, v1
    v_add3_u32 v2, v2, v93, s54
    v_add_u32 v3, 20480, v2
    v_add_u32 v4, 40960, v2
    v_add_u32 v5, 61440, v2
    v_add_u32 v6, 81920, v2
    v_add_u32 v7, 102400, v2
    v_add_u32 v8, 122880, v2
    v_add_u32 v9, 143360, v2
    s_cmp_eq_u32 s60, 2
    s_cselect_b32 s55, 0x10000, s54
    v_add_u32 v90, s55, v93
    s_cmp_eq_u32 s60, 1
    s_cselect_b32 s55, 0x10000, s54
    v_add_u32 v91, s55, v93
    v_mov_b32 v94, 8388607
    v_mov_b32 v10, 8388607
    v_mov_b32 v92, v93
    v_mov_b32 v95, 16
    s_mov_b64 s[86:87], 0
    v_add_u32 v158, s56, v161
    s_and_b32 s54, s29, 1
    s_lshl_b32 s54, s54, 1
    s_bitcmp1_b32 s29, 1
    s_cselect_b64 s[92:93], -1, 0
    s_cmp_lg_u32 s58, 0
    s_cbranch_scc1 K2_AGAIN
    s_waitcnt vmcnt(0) lgkmcnt(0)
K1_TAGP:
    v_readfirstlane_b32 s27, v60
    s_cmp_lg_u32 s27, 0
    s_cbranch_scc1 K1_TAG
    s_sub_u32 s28, s28, 1
    s_cbranch_scc1 K_END
    global_load_dword v60, v55, s[22:23] sc1
    s_waitcnt vmcnt(0)
    s_branch K1_TAGP
K1_TAG:
    v_lshl_or_b32 v63, v60, 16, v63
    s_barrier
    s_cmp_lg_u32 s26, 7
    s_cbranch_scc1 K1_PUB
    global_store_dwordx4 v59, v[60:63], s[24:25] sc1
K1_PUB:
    v_lshl_or_b32 v146, v149, 16, v148
    v_lshl_or_b32 v147, v151, 16, v150
    v_lshlrev_b32 v170, 3, v170
    v_lshlrev_b32 v77, 7, v75
    v_lshl_add_u32 v77, v76, 3, v77
    v_add_u32 v77, 75008, v77
    ds_read_b64_tr_b16 v[132:133], v77 offset:0
    ds_read_b64_tr_b16 v[136:137], v77 offset:32
    ds_read_b64_tr_b16 v[140:141], v77 offset:64
    ds_read_b64_tr_b16 v[144:145], v77 offset:96
    v_lshrrev_b32 v1, 5, v159
    v_mul_u32_u24 v77, 1056, v1
    v_bfe_u32 v1, v159, 2, 3
    v_lshl_add_u32 v77, v1, 7, v77
    v_lshl_add_u32 v77, v76, 4, v77
    v_add_u32 v77, 66560, v77
    ds_read_b64_tr_b16 v[98:99], v77 offset:0
    ds_read_b64_tr_b16 v[100:101], v77 offset:2112
    ds_read_b64_tr_b16 v[102:103], v77 offset:4224
    ds_read_b64_tr_b16 v[104:105], v77 offset:6336
    ds_read_b64_tr_b16 v[106:107], v77 offset:8
    ds_read_b64_tr_b16 v[108:109], v77 offset:2120
    ds_read_b64_tr_b16 v[110:111], v77 offset:4232
    ds_read_b64_tr_b16 v[112:113], v77 offset:6344
    s_mul_i32 s3, s2, 10000
    s_mul_i32 s55, s26, 1248
    s_add_u32 s3, s3, s55
    v_lshl_add_u32 v96, v159, 7, s3
    s_bfm_b64 exec, 10, 0
    global_load_dword v97, v96, s[4:5]
    s_mov_b64 exec, -1
    s_waitcnt lgkmcnt(4)
    ds_read_b64_tr_b16 v[114:115], v77 offset:64
    ds_read_b64_tr_b16 v[116:117], v77 offset:2176
    ds_read_b64_tr_b16 v[118:119], v77 offset:4288
    ds_read_b64_tr_b16 v[120:121], v77 offset:6400
    ds_read_b64_tr_b16 v[122:123], v77 offset:72
    ds_read_b64_tr_b16 v[124:125], v77 offset:2184
    ds_read_b64_tr_b16 v[126:127], v77 offset:4296
    ds_read_b64_tr_b16 v[128:129], v77 offset:6408
    v_lshlrev_b32 v130, 16, v132
    v_and_b32 v131, 0xffff0000, v132
    v_lshlrev_b32 v132, 16, v133
    v_and_b32 v133, 0xffff0000, v133
    v_lshlrev_b32 v134, 16, v136
    v_and_b32 v135, 0xffff0000, v136
    v_lshlrev_b32 v136, 16, v137
    v_and_b32 v137, 0xffff0000, v137
    v_lshlrev_b32 v138, 16, v140
    v_and_b32 v139, 0xffff0000, v140
    v_lshlrev_b32 v140, 16, v141
    v_and_b32 v141, 0xffff0000, v141
    v_lshlrev_b32 v142, 16, v144
    v_and_b32 v143, 0xffff0000, v144
    v_lshlrev_b32 v144, 16, v145
    v_and_b32 v145, 0xffff0000, v145
    s_waitcnt lgkmcnt(0)
    s_waitcnt vmcnt(0)
K2_AGAIN:
    s_mov_b64 exec, 0xffffffff
    s_branch K2_POLL0
K2_POLL:
    s_sub_u32 s28, s28, 1
    s_cbranch_scc1 K_END
    s_sleep 4
K2_POLL0:
    global_load_dwordx4 v[38:41], v80, s[24:25] sc1
K2_POLL1:
    s_waitcnt vmcnt(0)
K2_POLL2:
    v_cmp_ne_u32 vcc, s27, v38
    v_cmp_ne_u32_sdwa s[94:95], v38, v41 src0_sel:WORD_0 src1_sel:WORD_1
    s_or_b64 exec, vcc, s[94:95]
    s_cbranch_execnz K2_POLL
    s_mov_b64 exec, -1
    v_cndmask_b32 v38, v39, v40, s[92:93]
    v_cndmask_b32 v39, v40, v41, s[92:93]
    v_alignbyte_b32 v38, v39, v38, s54
    v_lshlrev_b32 v39, 16, v38
    v_sub_u32 v38, v38, v39
    ds_bpermute_b32 v30, v81, v38 offset:0
    ds_bpermute_b32 v31, v81, v38 offset:4
    ds_bpermute_b32 v32, v81, v38 offset:8
    ds_bpermute_b32 v33, v81, v38 offset:12
    ds_bpermute_b32 v34, v81, v38 offset:16
    ds_bpermute_b32 v35, v81, v38 offset:20
    ds_bpermute_b32 v36, v81, v38 offset:24
    ds_bpermute_b32 v37, v81, v38 offset:28
    s_waitcnt lgkmcnt(7)
    v_cmp_gt_u32_sdwa s[70:71], v30, v90 src0_sel:WORD_1 src1_sel:DWORD
    v_add_u32_sdwa v2, v30, v2 dst_sel:DWORD dst_unused:UNUSED_PAD src0_sel:WORD_0 src1_sel:DWORD
    s_waitcnt lgkmcnt(6)
    v_cmp_gt_u32_sdwa s[72:73], v31, v90 src0_sel:WORD_1 src1_sel:DWORD
    v_add_u32_sdwa v3, v31, v3 dst_sel:DWORD dst_unused:UNUSED_PAD src0_sel:WORD_0 src1_sel:DWORD
    v_cndmask_b32 v2, v94, v2, s[70:71]
    buffer_load_dword v11, v2, s[32:35], 0 idxen sc1
    s_waitcnt lgkmcnt(5)
    v_cmp_gt_u32_sdwa s[74:75], v32, v90 src0_sel:WORD_1 src1_sel:DWORD
    v_add_u32_sdwa v4, v32, v4 dst_sel:DWORD dst_unused:UNUSED_PAD src0_sel:WORD_0 src1_sel:DWORD
    v_cndmask_b32 v3, v94, v3, s[72:73]
    buffer_load_dword v12, v3, s[32:35], 0 idxen sc1
    s_waitcnt lgkmcnt(4)
    v_cmp_gt_u32_sdwa s[76:77], v33, v90 src0_sel:WORD_1 src1_sel:DWORD
    v_add_u32_sdwa v5, v33, v5 dst_sel:DWORD dst_unused:UNUSED_PAD src0_sel:WORD_0 src1_sel:DWORD
    v_cndmask_b32 v4, v94, v4, s[74:75]
    buffer_load_dword v13, v4, s[32:35], 0 idxen sc1
    s_waitcnt lgkmcnt(3)
    v_cmp_gt_u32_sdwa s[78:79], v34, v91 src0_sel:WORD_1 src1_sel:DWORD
    v_add_u32_sdwa v6, v34, v6 dst_sel:DWORD dst_unused:UNUSED_PAD src0_sel:WORD_0 src1_sel:DWORD
    v_cndmask_b32 v5, v94, v5, s[76:77]
    buffer_load_dword v14, v5, s[32:35], 0 idxen sc1
    s_waitcnt lgkmcnt(2)
    v_cmp_gt_u32_sdwa s[80:81], v35, v91 src0_sel:WORD_1 src1_sel:DWORD
    v_add_u32_sdwa v7, v35, v7 dst_sel:DWORD dst_unused:UNUSED_PAD src0_sel:WORD_0 src1_sel:DWORD
    v_cndmask_b32 v6, v94, v6, s[78:79]
    buffer_load_dword v15, v6, s[32:35], 0 idxen sc1
    s_waitcnt lgkmcnt(1)
    v_cmp_gt_u32_sdwa s[82:83], v36, v91 src0_sel:WORD_1 src1_sel:DWORD
    v_add_u32_sdwa v8, v36, v8 dst_sel:DWORD dst_unused:UNUSED_PAD src0_sel:WORD_0 src1_sel:DWORD
    v_cndmask_b32 v7, v94, v7, s[80:81]
    buffer_load_dword v16, v7, s[32:35], 0 idxen sc1
    s_waitcnt lgkmcnt(0)
    v_cmp_gt_u32_sdwa s[84:85], v37, v91 src0_sel:WORD_1 src1_sel:DWORD
    v_add_u32_sdwa v9, v37, v9 dst_sel:DWORD dst_unused:UNUSED_PAD src0_sel:WORD_0 src1_sel:DWORD
    v_cndmask_b32 v8, v94, v8, s[82:83]
    buffer_load_dword v17, v8, s[32:35], 0 idxen sc1
    v_cndmask_b32 v9, v94, v9, s[84:85]
    buffer_load_dword v18, v9, s[32:35], 0 idxen sc1
    v_lshrrev_b32 v38, 16, v38
    v_mov_b32 v39, 516
    s_mov_b64 exec, 0xffffffff
    ds_add_u32 v39, v38
    s_mov_b64 exec, -1
    v_max3_u32 v96, v30, v31, v32
    v_max3_u32 v97, v33, v34, v35
    v_max3_u32 v96, v96, v36, v37
    v_max_u32 v96, v96, v97
    v_cmp_lt_u32 vcc, 1114111, v96
    v_lshrrev_b32 v96, 16, v96
    s_cmp_lg_u32 s58, 0
    s_cbranch_scc1 K2_NOOVF
    s_cbranch_vccz K2_NOOVF
    v_cmp_lt_u32 vcc, 1114111, v30
    s_cbranch_vccz K2_OV0
    v_lshrrev_b32 v1, 16, v30
    v_sub_u32_e64 v1, v1, 16 clamp
    v_cmp_lt_u32 vcc, v92, v1
    v_add_u32 v97, v2, v95
    v_sub_u32 v92, v92, v1
    v_cndmask_b32_e64 v10, v10, v97, vcc
    v_sub_u32 v95, v95, v1
K2_OV0:
    v_cmp_lt_u32 vcc, 1114111, v31
    s_cbranch_vccz K2_OV1
    v_lshrrev_b32 v1, 16, v31
    v_sub_u32_e64 v1, v1, 16 clamp
    v_cmp_lt_u32 vcc, v92, v1
    v_add_u32 v97, v3, v95
    v_sub_u32 v92, v92, v1
    v_cndmask_b32_e64 v10, v10, v97, vcc
    v_sub_u32 v95, v95, v1
K2_OV1:
    v_cmp_lt_u32 vcc, 1114111, v32
    s_cbranch_vccz K2_OV2
    v_lshrrev_b32 v1, 16, v32
    v_sub_u32_e64 v1, v1, 16 clamp
    v_cmp_lt_u32 vcc, v92, v1
    v_add_u32 v97, v4, v95
    v_sub_u32 v92, v92, v1
    v_cndmask_b32_e64 v10, v10, v97, vcc
    v_sub_u32 v95, v95, v1
K2_OV2:
    v_cmp_lt_u32 vcc, 1114111, v33
    s_cbranch_vccz K2_OV3
    v_lshrrev_b32 v1, 16, v33
    v_sub_u32_e64 v1, v1, 16 clamp
    v_cmp_lt_u32 vcc, v92, v1
    v_add_u32 v97, v5, v95
    v_sub_u32 v92, v92, v1
    v_cndmask_b32_e64 v10, v10, v97, vcc
    v_sub_u32 v95, v95, v1
K2_OV3:
    v_cmp_lt_u32 vcc, 1114111, v34
    s_cbranch_vccz K2_OV4
    v_lshrrev_b32 v1, 16, v34
    v_sub_u32_e64 v1, v1, 16 clamp
    v_cmp_lt_u32 vcc, v92, v1
    v_add_u32 v97, v6, v95
    v_sub_u32 v92, v92, v1
    v_cndmask_b32_e64 v10, v10, v97, vcc
    v_sub_u32 v95, v95, v1
K2_OV4:
    v_cmp_lt_u32 vcc, 1114111, v35
    s_cbranch_vccz K2_OV5
    v_lshrrev_b32 v1, 16, v35
    v_sub_u32_e64 v1, v1, 16 clamp
    v_cmp_lt_u32 vcc, v92, v1
    v_add_u32 v97, v7, v95
    v_sub_u32 v92, v92, v1
    v_cndmask_b32_e64 v10, v10, v97, vcc
    v_sub_u32 v95, v95, v1
K2_OV5:
    v_cmp_lt_u32 vcc, 1114111, v36
    s_cbranch_vccz K2_OV6
    v_lshrrev_b32 v1, 16, v36
    v_sub_u32_e64 v1, v1, 16 clamp
    v_cmp_lt_u32 vcc, v92, v1
    v_add_u32 v97, v8, v95
    v_sub_u32 v92, v92, v1
    v_cndmask_b32_e64 v10, v10, v97, vcc
    v_sub_u32 v95, v95, v1
K2_OV6:
    v_cmp_lt_u32 vcc, 1114111, v37
    s_cbranch_vccz K2_OV7
    v_lshrrev_b32 v1, 16, v37
    v_sub_u32_e64 v1, v1, 16 clamp
    v_cmp_lt_u32 vcc, v92, v1
    v_add_u32 v97, v9, v95
    v_sub_u32 v92, v92, v1
    v_cndmask_b32_e64 v10, v10, v97, vcc
    v_sub_u32 v95, v95, v1
K2_OV7:
    v_cmp_ne_u32 s[86:87], v10, v94
K2_NOOVF:
    buffer_load_dword v19, v10, s[32:35], 0 idxen sc1
    s_waitcnt lgkmcnt(0)
    s_barrier
    ds_read_b32 v97, v39
    buffer_load_dwordx4 v[70:73], v10, s[36:39], 0 idxen sc1
    buffer_load_dwordx4 v[38:41], v2, s[36:39], 0 idxen sc1
    buffer_load_dwordx4 v[42:45], v3, s[36:39], 0 idxen sc1
    v_mov_b32 v92, 512
    v_mov_b32 v90, 4
    v_cmp_gt_i32 s[88:89], 0, v95
    s_waitcnt lgkmcnt(0)
    v_readfirstlane_b32 s3, v97
    s_sub_u32 s3, 2520, s3
    s_mul_i32 s3, s3, 20
    s_max_i32 s3, s3, 0
    s_min_i32 s3, s3, 1000
    s_sub_u32 s3, 5200, s3
    s_lshl_b32 s3, s3, 9
    s_sub_u32 s3, s3, 1
    s_cmp_lg_u32 s58, 0
    s_cselect_b32 s3, 2662399, s3
    s_mov_b32 s55, 0x0c0c0700
    s_waitcnt vmcnt(8)
    v_sub_u32 v29, s3, v11
    v_sub_u32 v30, s3, v12
    v_sub_u32 v31, s3, v13
    v_sub_u32 v32, s3, v14
    v_perm_b32 v29, v29, v11, s55
    v_perm_b32 v30, v30, v12, s55
    v_perm_b32 v31, v31, v13, s55
    v_perm_b32 v32, v32, v14, s55
    s_mov_b64 exec, s[70:71]
    ds_add_rtn_u32 v20, v29, v90 offset:0
    s_mov_b64 exec, s[72:73]
    ds_add_rtn_u32 v21, v30, v90 offset:0
    s_mov_b64 exec, s[74:75]
    ds_add_rtn_u32 v22, v31, v90 offset:0
    s_mov_b64 exec, s[76:77]
    ds_add_rtn_u32 v23, v32, v90 offset:0
    s_waitcnt vmcnt(3)
    s_mov_b64 exec, -1
    v_sub_u32 v33, s3, v15
    v_sub_u32 v34, s3, v16
    v_sub_u32 v35, s3, v17
    v_sub_u32 v36, s3, v18
    v_sub_u32 v37, s3, v19
    v_perm_b32 v33, v33, v15, s55
    v_perm_b32 v34, v34, v16, s55
    v_perm_b32 v35, v35, v17, s55
    v_perm_b32 v36, v36, v18, s55
    v_perm_b32 v37, v37, v19, s55
    s_mov_b64 exec, s[78:79]
    ds_add_rtn_u32 v24, v33, v90 offset:0
    s_mov_b64 exec, s[80:81]
    ds_add_rtn_u32 v25, v34, v90 offset:0
    s_mov_b64 exec, s[82:83]
    ds_add_rtn_u32 v26, v35, v90 offset:0
    s_mov_b64 exec, s[84:85]
    ds_add_rtn_u32 v27, v36, v90 offset:0
    s_mov_b64 exec, s[86:87]
    ds_add_rtn_u32 v28, v37, v90 offset:0
    s_mov_b64 exec, s[88:89]
    ds_max_u32 v92, v96
    s_mov_b64 exec, -1
    buffer_load_dwordx4 v[46:49], v4, s[36:39], 0 idxen sc1
    buffer_load_dwordx4 v[50:53], v5, s[36:39], 0 idxen sc1
    buffer_load_dwordx4 v[54:57], v6, s[36:39], 0 idxen sc1
    v_lshlrev_b32 v93, 2, v159
    s_waitcnt lgkmcnt(0)
    s_barrier
    ds_read2st64_b32 v[78:79], v93 offset0:0 offset1:255
    ds_read_b32 v92, v92
    buffer_load_dwordx4 v[58:61], v7, s[36:39], 0 idxen sc1
    buffer_load_dwordx4 v[62:65], v8, s[36:39], 0 idxen sc1
    v_mov_b32 v83, v159
    v_and_b32 v19, 0x7ffe00, v19
    s_waitcnt lgkmcnt(1)
    v_add_u32 v80, v78, v79
    v_add_u32 v80, -128, v80
    v_med3_i32 v80, v80, 0, s48
    v_bfe_i32 v84, v80, 2, 1
    v_cmp_ne_u32 s[88:89], 0, v84
    v_bfe_i32 v85, v80, 3, 1
    v_cmp_ne_u32 s[90:91], 0, v85
    v_bfe_i32 v86, v80, 4, 1
    v_cmp_ne_u32 s[92:93], 0, v86
    v_bfe_i32 v87, v80, 5, 1
    v_cmp_ne_u32 s[94:95], 0, v87
    v_bfe_i32 v88, v80, 6, 1
    v_cmp_ne_u32 s[96:97], 0, v88
    v_bfe_i32 v89, v80, 7, 1
    v_cmp_ne_u32 s[98:99], 0, v89
    v_lshl_or_b32 v82, v79, 16, v78
    v_bitop3_b32 v94, v172, s88, v84 bitop3:0xd4
    v_bitop3_b32 v95, v173, s89, v84 bitop3:0xd4
    v_bitop3_b32 v94, v94, s90, v85 bitop3:0xd4
    v_bitop3_b32 v95, v95, s91, v85 bitop3:0xd4
    v_bitop3_b32 v94, v94, s92, v86 bitop3:0xd4
    v_bitop3_b32 v95, v95, s93, v86 bitop3:0xd4
    v_bitop3_b32 v94, v94, s94, v87 bitop3:0xd4
    v_bitop3_b32 v95, v95, s95, v87 bitop3:0xd4
    v_bitop3_b32 v94, v94, s96, v88 bitop3:0xd4
    v_bitop3_b32 v95, v95, s97, v88 bitop3:0xd4
    v_bitop3_b32 v94, v94, s98, v89 bitop3:0xd4
    v_bitop3_b32 v95, v95, s99, v89 bitop3:0xd4
    v_bcnt_u32_b32 v94, v94, 0
    v_bcnt_u32_b32 v94, v95, v94
    v_lshlrev_b32 v94, 3, v94
    ds_write_b64 v94, v[82:83] offset:1024
    ds_read_b64 v[82:83], v170 offset:1024
    buffer_load_dwordx4 v[66:69], v9, s[36:39], 0 idxen sc1
    s_movk_i32 s53, 256
    s_lshl_b32 s52, s26, 3
    s_add_u32 s3, s52, 7
    s_waitcnt lgkmcnt(0)
    v_and_b32_dpp v79, v82, v171 row_shr:1 row_mask:0xf bank_mask:0xf bound_ctrl:0
    v_add_u32 v78, v82, v79
    v_readfirstlane_b32 s54, v92
    v_mov_b32 v154, v83
    v_and_b32_dpp v79, v78, v174 row_shr:2 row_mask:0xf bank_mask:0xf bound_ctrl:0
    v_add_u32 v78, v78, v79
    v_lshl_add_u32 v83, v83, 2, s53
    v_and_b32 v18, 0x7ffe00, v18
    v_add_u32_dpp v78, v78, v78 row_shr:4 row_mask:0xf bank_mask:0xa
    v_and_b32 v17, 0x7ffe00, v17
    v_and_b32 v16, 0x7ffe00, v16
    v_mov_b32_dpp v80, v78 row_newbcast:7 row_mask:0xf bank_mask:0x3
    v_and_b32 v15, 0x7ffe00, v15
    v_and_b32 v14, 0x7ffe00, v14
    v_mov_b32_dpp v80, v78 row_newbcast:15 row_mask:0xf bank_mask:0xc
    v_add_u32_sdwa v81, v80, v80 dst_sel:DWORD dst_unused:UNUSED_PAD src0_sel:WORD_0 src1_sel:WORD_1
    v_add_u32 v81, 31, v81
    v_and_b32 v81, -32, v81
    v_and_b32 v13, 0x7ffe00, v13
    v_and_b32 v12, 0x7ffe00, v12
    v_add_u32_dpp v79, v81, v81 row_ror:8 row_mask:0xf bank_mask:0xf
    v_mov_b32_dpp v84, v81 row_shr:8 row_mask:0xf bank_mask:0xf bound_ctrl:0
    v_sub_u32 v84, v84, v79
    v_add_u32_dpp v79, v79, v79 row_bcast:15 row_mask:0xa bank_mask:0xf
    v_add_u32 v84, 66560, v84
    v_and_b32 v11, 0x7ffe00, v11
    v_add_u32_dpp v79, v79, v79 row_bcast:31 row_mask:0xc bank_mask:0xf
    v_add_u32 v84, v84, v79
    v_add_u32_sdwa v152, v84, v78 dst_sel:DWORD dst_unused:UNUSED_PAD src0_sel:DWORD src1_sel:WORD_0
    v_add_u32_sdwa v80, v84, v80 dst_sel:DWORD dst_unused:UNUSED_PAD src0_sel:DWORD src1_sel:WORD_0
    v_add_u32_sdwa v153, v80, v78 dst_sel:DWORD dst_unused:UNUSED_PAD src0_sel:DWORD src1_sel:WORD_1
    v_sub_u32_sdwa v86, v152, v82 dst_sel:DWORD dst_unused:UNUSED_PAD src0_sel:DWORD src1_sel:WORD_0
    v_sub_u32_sdwa v87, v153, v82 dst_sel:DWORD dst_unused:UNUSED_PAD src0_sel:DWORD src1_sel:WORD_1
    ds_write2st64_b32 v83, v86, v87 offset0:0 offset1:255
    ds_read_b32 v29, v29 offset:256
    ds_read_b32 v30, v30 offset:256
    ds_read_b32 v31, v31 offset:256
    ds_read_b32 v32, v32 offset:256
    ds_read_b32 v33, v33 offset:256
    ds_read_b32 v34, v34 offset:256
    ds_read_b32 v35, v35 offset:256
    ds_read_b32 v36, v36 offset:256
    ds_read_b32 v37, v37 offset:256
    v_readlane_b32 s55, v79, 63
    v_readlane_b32 s50, v84, s52
    v_readlane_b32 s53, v153, s3
    v_readlane_b32 s51, v152, s52
    s_cmp_lg_u32 s58, 0
    s_cbranch_scc1 K2_FEAS
    s_cmp_gt_u32 s55, 12672
    s_cbranch_scc1 K2_GOSLOW
    s_cmp_lg_u32 s54, 0
    s_cbranch_scc1 K2_GOSLOW
K2_FEAS:
    v_mov_b32 v79, 8388096
    s_sub_u32 s3, 0, s53
    s_bfe_u32 s3, s3, 0x30002
    s_cmp_eq_u32 s26, 7
    s_cselect_b32 s3, 32, s3
    v_lshl_add_u32 v78, v159, 2, s53
    v_add_u32 v157, s50, v166
    s_waitcnt lgkmcnt(0)
    s_mov_b64 exec, s[70:71]
    v_add_u32 v29, v29, v20
    ds_write_b32 v29, v11
    s_mov_b64 exec, s[72:73]
    v_add_u32 v30, v30, v21
    ds_write_b32 v30, v12
    s_mov_b64 exec, s[74:75]
    v_add_u32 v31, v31, v22
    ds_write_b32 v31, v13
    s_mov_b64 exec, s[76:77]
    v_add_u32 v32, v32, v23
    ds_write_b32 v32, v14
    s_mov_b64 exec, s[78:79]
    v_add_u32 v33, v33, v24
    ds_write_b32 v33, v15
    s_mov_b64 exec, s[80:81]
    v_add_u32 v34, v34, v25
    ds_write_b32 v34, v16
    s_mov_b64 exec, s[82:83]
    v_add_u32 v35, v35, v26
    ds_write_b32 v35, v17
    s_mov_b64 exec, s[84:85]
    v_add_u32 v36, v36, v27
    ds_write_b32 v36, v18
    s_mov_b64 exec, s[86:87]
    v_add_u32 v37, v37, v28
    ds_write_b32 v37, v19
    s_bfm_b64 exec, s3, 0
    ds_write_b32 v78, v79
    s_mov_b64 exec, -1
    v_lshl_add_u32 v29, v29, 2, s47
    v_lshl_add_u32 v30, v30, 2, s47
    v_lshl_add_u32 v31, v31, 2, s47
    v_lshl_add_u32 v32, v32, 2, s47
    v_lshl_add_u32 v33, v33, 2, s47
    v_lshl_add_u32 v34, v34, 2, s47
    v_lshl_add_u32 v35, v35, 2, s47
    v_lshl_add_u32 v36, v36, 2, s47
    v_lshl_add_u32 v37, v37, 2, s47
    s_cmp_lt_u32 s50, s53
    s_cselect_b64 s[88:89], -1, 1
    s_add_u32 s3, s50, 32
    s_cmp_lt_u32 s3, s53
    s_cselect_b64 s[90:91], -1, 1
    s_mov_b32 m0, s56
    s_mov_b32 s42, 5123136
    s_waitcnt lgkmcnt(0)
    s_barrier
    ds_read_b128 v[78:81], v157 offset:0
    ds_read_b128 v[82:85], v157 offset:32
    ds_read_b128 v[148:151], v157 offset:64
    v_lshl_add_u32 v155, s50, 2, v164
    v_lshl_add_u32 v156, s50, 2, v165
    v_add_u32 v157, 96, v157
    s_waitcnt lgkmcnt(1)
    v_add_u32 v78, v78, v160
    v_add_u32 v79, v79, v160
    v_add_u32 v80, v80, v160
    v_add_u32 v81, v81, v160
    v_add_u32 v82, v82, v160
    v_add_u32 v83, v83, v160
    v_add_u32 v84, v84, v160
    v_add_u32 v85, v85, v160
    s_mov_b64 exec, s[88:89]
    buffer_load_dwordx4 v78, s[40:43], s44 offen offset:0 lds
    buffer_load_dwordx4 v79, s[40:43], s45 offen offset:1056 lds
    buffer_load_dwordx4 v80, s[40:43], s46 offen offset:2080 lds
    buffer_load_dwordx4 v81, s[40:43], 0 offen offset:3136 lds
    s_waitcnt vmcnt(12)
    s_mov_b64 exec, s[86:87]
    ds_write_b128 v37, v[70:73]
    s_waitcnt vmcnt(11)
    s_mov_b64 exec, s[70:71]
    ds_write_b128 v29, v[38:41]
    s_waitcnt vmcnt(10)
    s_mov_b64 exec, s[72:73]
    ds_write_b128 v30, v[42:45]
    s_waitcnt vmcnt(9)
    s_mov_b64 exec, s[74:75]
    ds_write_b128 v31, v[46:49]
    s_waitcnt vmcnt(8)
    s_mov_b64 exec, s[76:77]
    ds_write_b128 v32, v[50:53]
    s_waitcnt vmcnt(7)
    s_mov_b64 exec, s[78:79]
    ds_write_b128 v33, v[54:57]
    s_waitcnt vmcnt(6)
    s_mov_b64 exec, s[80:81]
    ds_write_b128 v34, v[58:61]
    s_waitcnt vmcnt(5)
    s_mov_b64 exec, s[82:83]
    ds_write_b128 v35, v[62:65]
    s_waitcnt vmcnt(4)
    s_mov_b64 exec, s[84:85]
    ds_write_b128 v36, v[66:69]
    s_add_u32 m0, m0, 4160
    s_mov_b64 exec, s[90:91]
    buffer_load_dwordx4 v82, s[40:43], s44 offen offset:0 lds
    buffer_load_dwordx4 v83, s[40:43], s45 offen offset:1056 lds
    buffer_load_dwordx4 v84, s[40:43], s46 offen offset:2080 lds
    buffer_load_dwordx4 v85, s[40:43], 0 offen offset:3136 lds
    s_mov_b64 exec, -1
    s_mov_b32 m0, s56
    s_cmp_lt_u32 s26, 4
    s_cbranch_scc1 K2_PR0
    s_setprio 1
K2_PR0:
    s_waitcnt lgkmcnt(0)
    v_mov_b32 v38, 0
    v_mov_b32 v40, 0
    s_barrier
    ds_read_b64 v[34:35], v155
    ds_read_u16_d16_hi v38, v156 offset:8
    ds_read_u16_d16_hi v40, v156 offset:72
    s_cmp_eq_u32 s50, s53
    s_cselect_b32 s49, 1, 0
    s_cbranch_scc1 K2_MID
    s_sub_u32 s53, s53, 32
    s_branch K2_L0
.p2align 3
K2_M0:
    v_mfma_f32_16x16x32_bf16 v[176:179], v[26:29], v[2:5], v[176:179]
    v_mfma_f32_16x16x32_bf16 v[180:183], v[26:29], v[6:9], v[180:183]
    v_mfma_f32_16x16x32_bf16 v[184:187], v[26:29], v[10:13], v[184:187]
    v_mfma_f32_16x16x32_bf16 v[188:191], v[26:29], v[14:17], v[188:191]
K2_L0:
    s_waitcnt vmcnt(4)
    s_add_u32 s50, s50, 32
    ds_read_b64_tr_b16 v[2:3], v158 offset:0
    ds_read_b64_tr_b16 v[4:5], v158 offset:512
    ds_read_b64_tr_b16 v[6:7], v158 offset:32
    ds_read_b64_tr_b16 v[8:9], v158 offset:544
    ds_read_b64_tr_b16 v[10:11], v158 offset:256
    ds_read_b64_tr_b16 v[12:13], v158 offset:768
    ds_read_b64_tr_b16 v[14:15], v158 offset:288
    ds_read_b64_tr_b16 v[16:17], v158 offset:800
    s_cmp_lt_i32 s50, s53
    s_waitcnt lgkmcnt(8)
    v_mfma_f32_4x4x4_16b_bf16 v[30:33], v[34:35], v[146:147], 0
    v_add_u32 v42, v148, v160
    v_add_u32 v43, v149, v160
    v_add_u32 v44, v150, v160
    v_add_u32 v45, v151, v160
    ds_read_b128 v[148:151], v157
    v_add_u32 v155, v155, v169
    v_add_u32 v156, v156, v169
    v_mfma_f32_4x4x1_16b_f32 v[18:21], v30, v38, 0
    v_mfma_f32_4x4x1_16b_f32 v[22:25], v31, v40, 0
    ds_read_b64 v[34:35], v155
    ds_read_u16_d16_hi v38, v156 offset:8
    ds_read_u16_d16_hi v40, v156 offset:72
    s_cselect_b32 s42, 5123136, 0
    s_cselect_b64 exec, -1, 1
    s_waitcnt lgkmcnt(4)
    buffer_load_dwordx4 v42, s[40:43], s44 offen offset:0 lds
    buffer_load_dwordx4 v43, s[40:43], s45 offen offset:1056 lds
    buffer_load_dwordx4 v44, s[40:43], s46 offen offset:2080 lds
    buffer_load_dwordx4 v45, s[40:43], 0 offen offset:3136 lds
    s_mov_b64 exec, -1
    s_xor_b32 m0, m0, s57
    v_cvt_pk_bf16_f32 v26, v18, v19
    v_cvt_pk_bf16_f32 v27, v20, v21
    v_cvt_pk_bf16_f32 v28, v22, v23
    v_cvt_pk_bf16_f32 v29, v24, v25
    v_add_u32 v158, m0, v161
    v_add_u32 v157, 32, v157
    s_cmp_gt_u32 s51, s50
    s_cbranch_scc1 K2_M0
K2_B0:
    s_sub_u32 s3, s50, s51
    s_add_u32 s52, s52, 1
    v_cmp_lt_u32 s[70:71], s3, v167
    v_cmp_lt_u32 s[72:73], s3, v168
    v_readlane_b32 s51, v152, s52
    v_cndmask_b32 v30, 0, v26, s[70:71]
    v_cndmask_b32 v31, 0, v27, s[70:71]
    v_cndmask_b32 v32, 0, v28, s[72:73]
    v_cndmask_b32 v33, 0, v29, s[72:73]
    v_xor_b32 v26, v26, v30
    v_xor_b32 v27, v27, v31
    v_xor_b32 v28, v28, v32
    v_xor_b32 v29, v29, v33
    v_mfma_f32_16x16x32_bf16 v[176:179], v[30:33], v[2:5], v[176:179]
    v_mfma_f32_16x16x32_bf16 v[180:183], v[30:33], v[6:9], v[180:183]
    v_mfma_f32_16x16x32_bf16 v[184:187], v[30:33], v[10:13], v[184:187]
    v_mfma_f32_16x16x32_bf16 v[188:191], v[30:33], v[14:17], v[188:191]
    s_cmp_gt_u32 s51, s50
    s_cbranch_scc0 K2_B1
    s_cmp_eq_u32 s3, 0
    s_cbranch_scc1 K2_L1
K2_M1:
    v_mfma_f32_16x16x32_bf16 v[192:195], v[26:29], v[2:5], v[192:195]
    v_mfma_f32_16x16x32_bf16 v[196:199], v[26:29], v[6:9], v[196:199]
    v_mfma_f32_16x16x32_bf16 v[200:203], v[26:29], v[10:13], v[200:203]
    v_mfma_f32_16x16x32_bf16 v[204:207], v[26:29], v[14:17], v[204:207]
K2_L1:
    s_waitcnt vmcnt(4)
    s_add_u32 s50, s50, 32
    ds_read_b64_tr_b16 v[2:3], v158 offset:0
    ds_read_b64_tr_b16 v[4:5], v158 offset:512
    ds_read_b64_tr_b16 v[6:7], v158 offset:32
    ds_read_b64_tr_b16 v[8:9], v158 offset:544
    ds_read_b64_tr_b16 v[10:11], v158 offset:256
    ds_read_b64_tr_b16 v[12:13], v158 offset:768
    ds_read_b64_tr_b16 v[14:15], v158 offset:288
    ds_read_b64_tr_b16 v[16:17], v158 offset:800
    s_cmp_lt_i32 s50, s53
    s_waitcnt lgkmcnt(8)
    v_mfma_f32_4x4x4_16b_bf16 v[30:33], v[34:35], v[146:147], 0
    v_add_u32 v42, v148, v160
    v_add_u32 v43, v149, v160
    v_add_u32 v44, v150, v160
    v_add_u32 v45, v151, v160
    ds_read_b128 v[148:151], v157
    v_add_u32 v155, v155, v169
    v_add_u32 v156, v156, v169
    v_mfma_f32_4x4x1_16b_f32 v[18:21], v30, v38, 0
    v_mfma_f32_4x4x1_16b_f32 v[22:25], v31, v40, 0
    ds_read_b64 v[34:35], v155
    ds_read_u16_d16_hi v38, v156 offset:8
    ds_read_u16_d16_hi v40, v156 offset:72
    s_cselect_b32 s42, 5123136, 0
    s_cselect_b64 exec, -1, 1
    s_waitcnt lgkmcnt(4)
    buffer_load_dwordx4 v42, s[40:43], s44 offen offset:0 lds
    buffer_load_dwordx4 v43, s[40:43], s45 offen offset:1056 lds
    buffer_load_dwordx4 v44, s[40:43], s46 offen offset:2080 lds
    buffer_load_dwordx4 v45, s[40:43], 0 offen offset:3136 lds
    s_mov_b64 exec, -1
    s_xor_b32 m0, m0, s57
    v_cvt_pk_bf16_f32 v26, v18, v19
    v_cvt_pk_bf16_f32 v27, v20, v21
    v_cvt_pk_bf16_f32 v28, v22, v23
    v_cvt_pk_bf16_f32 v29, v24, v25
    v_add_u32 v158, m0, v161
    v_add_u32 v157, 32, v157
    s_cmp_gt_u32 s51, s50
    s_cbranch_scc1 K2_M1
K2_B1:
    s_sub_u32 s3, s50, s51
    s_add_u32 s52, s52, 1
    v_cmp_lt_u32 s[70:71], s3, v167
    v_cmp_lt_u32 s[72:73], s3, v168
    v_readlane_b32 s51, v152, s52
    v_cndmask_b32 v30, 0, v26, s[70:71]
    v_cndmask_b32 v31, 0, v27, s[70:71]
    v_cndmask_b32 v32, 0, v28, s[72:73]
    v_cndmask_b32 v33, 0, v29, s[72:73]
    v_xor_b32 v26, v26, v30
    v_xor_b32 v27, v27, v31
    v_xor_b32 v28, v28, v32
    v_xor_b32 v29, v29, v33
    v_mfma_f32_16x16x32_bf16 v[192:195], v[30:33], v[2:5], v[192:195]
    v_mfma_f32_16x16x32_bf16 v[196:199], v[30:33], v[6:9], v[196:199]
    v_mfma_f32_16x16x32_bf16 v[200:203], v[30:33], v[10:13], v[200:203]
    v_mfma_f32_16x16x32_bf16 v[204:207], v[30:33], v[14:17], v[204:207]
    s_cmp_eq_u32 s49, 2
    s_cbranch_scc1 K2_R1
K2_C1:
    s_cmp_gt_u32 s51, s50
    s_cbranch_scc0 K2_B2
    s_cmp_eq_u32 s3, 0
    s_cbranch_scc1 K2_L2
K2_M2:
    v_mfma_f32_16x16x32_bf16 v[208:211], v[26:29], v[2:5], v[208:211]
    v_mfma_f32_16x16x32_bf16 v[212:215], v[26:29], v[6:9], v[212:215]
    v_mfma_f32_16x16x32_bf16 v[216:219], v[26:29], v[10:13], v[216:219]
    v_mfma_f32_16x16x32_bf16 v[220:223], v[26:29], v[14:17], v[220:223]
K2_L2:
    s_waitcnt vmcnt(4)
    s_add_u32 s50, s50, 32
    ds_read_b64_tr_b16 v[2:3], v158 offset:0
    ds_read_b64_tr_b16 v[4:5], v158 offset:512
    ds_read_b64_tr_b16 v[6:7], v158 offset:32
    ds_read_b64_tr_b16 v[8:9], v158 offset:544
    ds_read_b64_tr_b16 v[10:11], v158 offset:256
    ds_read_b64_tr_b16 v[12:13], v158 offset:768
    ds_read_b64_tr_b16 v[14:15], v158 offset:288
    ds_read_b64_tr_b16 v[16:17], v158 offset:800
    s_cmp_lt_i32 s50, s53
    s_waitcnt lgkmcnt(8)
    v_mfma_f32_4x4x4_16b_bf16 v[30:33], v[34:35], v[146:147], 0
    v_add_u32 v42, v148, v160
    v_add_u32 v43, v149, v160
    v_add_u32 v44, v150, v160
    v_add_u32 v45, v151, v160
    ds_read_b128 v[148:151], v157
    v_add_u32 v155, v155, v169
    v_add_u32 v156, v156, v169
    v_mfma_f32_4x4x1_16b_f32 v[18:21], v30, v38, 0
    v_mfma_f32_4x4x1_16b_f32 v[22:25], v31, v40, 0
    ds_read_b64 v[34:35], v155
    ds_read_u16_d16_hi v38, v156 offset:8
    ds_read_u16_d16_hi v40, v156 offset:72
    s_cselect_b32 s42, 5123136, 0
    s_cselect_b64 exec, -1, 1
    s_waitcnt lgkmcnt(4)
    buffer_load_dwordx4 v42, s[40:43], s44 offen offset:0 lds
    buffer_load_dwordx4 v43, s[40:43], s45 offen offset:1056 lds
    buffer_load_dwordx4 v44, s[40:43], s46 offen offset:2080 lds
    buffer_load_dwordx4 v45, s[40:43], 0 offen offset:3136 lds
    s_mov_b64 exec, -1
    s_xor_b32 m0, m0, s57
    v_cvt_pk_bf16_f32 v26, v18, v19
    v_cvt_pk_bf16_f32 v27, v20, v21
    v_cvt_pk_bf16_f32 v28, v22, v23
    v_cvt_pk_bf16_f32 v29, v24, v25
    v_add_u32 v158, m0, v161
    v_add_u32 v157, 32, v157
    s_cmp_gt_u32 s51, s50
    s_cbranch_scc1 K2_M2
K2_B2:
    s_sub_u32 s3, s50, s51
    s_add_u32 s52, s52, 1
    v_cmp_lt_u32 s[70:71], s3, v167
    v_cmp_lt_u32 s[72:73], s3, v168
    v_readlane_b32 s51, v152, s52
    v_cndmask_b32 v30, 0, v26, s[70:71]
    v_cndmask_b32 v31, 0, v27, s[70:71]
    v_cndmask_b32 v32, 0, v28, s[72:73]
    v_cndmask_b32 v33, 0, v29, s[72:73]
    v_xor_b32 v26, v26, v30
    v_xor_b32 v27, v27, v31
    v_xor_b32 v28, v28, v32
    v_xor_b32 v29, v29, v33
    v_mfma_f32_16x16x32_bf16 v[208:211], v[30:33], v[2:5], v[208:211]
    v_mfma_f32_16x16x32_bf16 v[212:215], v[30:33], v[6:9], v[212:215]
    v_mfma_f32_16x16x32_bf16 v[216:219], v[30:33], v[10:13], v[216:219]
    v_mfma_f32_16x16x32_bf16 v[220:223], v[30:33], v[14:17], v[220:223]
    s_cmp_eq_u32 s49, 2
    s_cbranch_scc1 K2_R2
K2_C2:
    s_cmp_gt_u32 s51, s50
    s_cbranch_scc0 K2_B3
    s_cmp_eq_u32 s3, 0
    s_cbranch_scc1 K2_L3
K2_M3:
    v_mfma_f32_16x16x32_bf16 v[224:227], v[26:29], v[2:5], v[224:227]
    v_mfma_f32_16x16x32_bf16 v[228:231], v[26:29], v[6:9], v[228:231]
    v_mfma_f32_16x16x32_bf16 v[232:235], v[26:29], v[10:13], v[232:235]
    v_mfma_f32_16x16x32_bf16 v[236:239], v[26:29], v[14:17], v[236:239]
K2_L3:
    s_waitcnt vmcnt(4)
    s_add_u32 s50, s50, 32
    ds_read_b64_tr_b16 v[2:3], v158 offset:0
    ds_read_b64_tr_b16 v[4:5], v158 offset:512
    ds_read_b64_tr_b16 v[6:7], v158 offset:32
    ds_read_b64_tr_b16 v[8:9], v158 offset:544
    ds_read_b64_tr_b16 v[10:11], v158 offset:256
    ds_read_b64_tr_b16 v[12:13], v158 offset:768
    ds_read_b64_tr_b16 v[14:15], v158 offset:288
    ds_read_b64_tr_b16 v[16:17], v158 offset:800
    s_cmp_lt_i32 s50, s53
    s_waitcnt lgkmcnt(8)
    v_mfma_f32_4x4x4_16b_bf16 v[30:33], v[34:35], v[146:147], 0
    v_add_u32 v42, v148, v160
    v_add_u32 v43, v149, v160
    v_add_u32 v44, v150, v160
    v_add_u32 v45, v151, v160
    ds_read_b128 v[148:151], v157
    v_add_u32 v155, v155, v169
    v_add_u32 v156, v156, v169
    v_mfma_f32_4x4x1_16b_f32 v[18:21], v30, v38, 0
    v_mfma_f32_4x4x1_16b_f32 v[22:25], v31, v40, 0
    ds_read_b64 v[34:35], v155
    ds_read_u16_d16_hi v38, v156 offset:8
    ds_read_u16_d16_hi v40, v156 offset:72
    s_cselect_b32 s42, 5123136, 0
    s_cselect_b64 exec, -1, 1
    s_waitcnt lgkmcnt(4)
    buffer_load_dwordx4 v42, s[40:43], s44 offen offset:0 lds
    buffer_load_dwordx4 v43, s[40:43], s45 offen offset:1056 lds
    buffer_load_dwordx4 v44, s[40:43], s46 offen offset:2080 lds
    buffer_load_dwordx4 v45, s[40:43], 0 offen offset:3136 lds
    s_mov_b64 exec, -1
    s_xor_b32 m0, m0, s57
    v_cvt_pk_bf16_f32 v26, v18, v19
    v_cvt_pk_bf16_f32 v27, v20, v21
    v_cvt_pk_bf16_f32 v28, v22, v23
    v_cvt_pk_bf16_f32 v29, v24, v25
    v_add_u32 v158, m0, v161
    v_add_u32 v157, 32, v157
    s_cmp_gt_u32 s51, s50
    s_cbranch_scc1 K2_M3
K2_B3:
    s_sub_u32 s3, s50, s51
    s_add_u32 s52, s52, 1
    v_cmp_lt_u32 s[70:71], s3, v167
    v_cmp_lt_u32 s[72:73], s3, v168
    v_readlane_b32 s51, v152, s52
    v_cndmask_b32 v30, 0, v26, s[70:71]
    v_cndmask_b32 v31, 0, v27, s[70:71]
    v_cndmask_b32 v32, 0, v28, s[72:73]
    v_cndmask_b32 v33, 0, v29, s[72:73]
    v_xor_b32 v26, v26, v30
    v_xor_b32 v27, v27, v31
    v_xor_b32 v28, v28, v32
    v_xor_b32 v29, v29, v33
    v_mfma_f32_16x16x32_bf16 v[224:227], v[30:33], v[2:5], v[224:227]
    v_mfma_f32_16x16x32_bf16 v[228:231], v[30:33], v[6:9], v[228:231]
    v_mfma_f32_16x16x32_bf16 v[232:235], v[30:33], v[10:13], v[232:235]
    v_mfma_f32_16x16x32_bf16 v[236:239], v[30:33], v[14:17], v[236:239]
    s_cmp_eq_u32 s49, 2
    s_cbranch_scc1 K2_R3
K2_C3:
    s_cmp_gt_u32 s51, s50
    s_cbranch_scc0 K2_B4
    s_cmp_eq_u32 s3, 0
    s_cbranch_scc1 K2_L4
K2_M4:
    v_mfma_f32_16x16x32_bf16 v[240:243], v[26:29], v[2:5], v[240:243]
    v_mfma_f32_16x16x32_bf16 v[244:247], v[26:29], v[6:9], v[244:247]
    v_mfma_f32_16x16x32_bf16 v[248:251], v[26:29], v[10:13], v[248:251]
    v_mfma_f32_16x16x32_bf16 v[252:255], v[26:29], v[14:17], v[252:255]
K2_L4:
    s_waitcnt vmcnt(4)
    s_add_u32 s50, s50, 32
    ds_read_b64_tr_b16 v[2:3], v158 offset:0
    ds_read_b64_tr_b16 v[4:5], v158 offset:512
    ds_read_b64_tr_b16 v[6:7], v158 offset:32
    ds_read_b64_tr_b16 v[8:9], v158 offset:544
    ds_read_b64_tr_b16 v[10:11], v158 offset:256
    ds_read_b64_tr_b16 v[12:13], v158 offset:768
    ds_read_b64_tr_b16 v[14:15], v158 offset:288
    ds_read_b64_tr_b16 v[16:17], v158 offset:800
    s_cmp_lt_i32 s50, s53
    s_waitcnt lgkmcnt(8)
    v_mfma_f32_4x4x4_16b_bf16 v[30:33], v[34:35], v[146:147], 0
    v_add_u32 v42, v148, v160
    v_add_u32 v43, v149, v160
    v_add_u32 v44, v150, v160
    v_add_u32 v45, v151, v160
    ds_read_b128 v[148:151], v157
    v_add_u32 v155, v155, v169
    v_add_u32 v156, v156, v169
    v_mfma_f32_4x4x1_16b_f32 v[18:21], v30, v38, 0
    v_mfma_f32_4x4x1_16b_f32 v[22:25], v31, v40, 0
    ds_read_b64 v[34:35], v155
    ds_read_u16_d16_hi v38, v156 offset:8
    ds_read_u16_d16_hi v40, v156 offset:72
    s_cselect_b32 s42, 5123136, 0
    s_cselect_b64 exec, -1, 1
    s_waitcnt lgkmcnt(4)
    buffer_load_dwordx4 v42, s[40:43], s44 offen offset:0 lds
    buffer_load_dwordx4 v43, s[40:43], s45 offen offset:1056 lds
    buffer_load_dwordx4 v44, s[40:43], s46 offen offset:2080 lds
    buffer_load_dwordx4 v45, s[40:43], 0 offen offset:3136 lds
    s_mov_b64 exec, -1
    s_xor_b32 m0, m0, s57
    v_cvt_pk_bf16_f32 v26, v18, v19
    v_cvt_pk_bf16_f32 v27, v20, v21
    v_cvt_pk_bf16_f32 v28, v22, v23
    v_cvt_pk_bf16_f32 v29, v24, v25
    v_add_u32 v158, m0, v161
    v_add_u32 v157, 32, v157
    s_cmp_gt_u32 s51, s50
    s_cbranch_scc1 K2_M4
K2_B4:
    s_sub_u32 s3, s50, s51
    s_add_u32 s52, s52, -4
    v_cmp_lt_u32 s[70:71], s3, v167
    v_cmp_lt_u32 s[72:73], s3, v168
    v_readlane_b32 s51, v153, s52
    v_cndmask_b32 v30, 0, v26, s[70:71]
    v_cndmask_b32 v31, 0, v27, s[70:71]
    v_cndmask_b32 v32, 0, v28, s[72:73]
    v_cndmask_b32 v33, 0, v29, s[72:73]
    v_xor_b32 v26, v26, v30
    v_xor_b32 v27, v27, v31
    v_xor_b32 v28, v28, v32
    v_xor_b32 v29, v29, v33
    v_mfma_f32_16x16x32_bf16 v[240:243], v[30:33], v[2:5], v[240:243]
    v_mfma_f32_16x16x32_bf16 v[244:247], v[30:33], v[6:9], v[244:247]
    v_mfma_f32_16x16x32_bf16 v[248:251], v[30:33], v[10:13], v[248:251]
    v_mfma_f32_16x16x32_bf16 v[252:255], v[30:33], v[14:17], v[252:255]
    s_cmp_lg_u32 s49, 0
    s_cbranch_scc1 K2_DONE
K2_MID:
    v_add_lshl_u32 v1, v76, s52, 2
    ds_bpermute_b32 v47, v1, v154
    s_add_u32 s54, s52, 4
    v_readlane_b32 s54, v154, s54
    v_lshlrev_b32 v1, 7, v75
    v_lshl_add_u32 v1, v74, 4, v1
    s_cmp_lt_u32 s54, s31
    s_cselect_b32 s86, 0x11111111, 0
    s_mov_b32 s87, s86
    s_add_u32 s54, s54, s30
    v_lshl_add_u32 v48, s54, 9, v1
    s_waitcnt lgkmcnt(0)
    v_add_u32 v47, s30, v47
    v_lshl_add_u32 v47, v47, 9, v1
    v_mov_b32 v152, v153
    s_setprio 0
    s_cmp_lg_u32 s49, 0
    s_cbranch_scc1 K2_DONE
    s_sub_u32 s49, 2, s58
    s_cmp_gt_u32 s51, s50
    s_cbranch_scc0 K2_B0
    s_cmp_eq_u32 s3, 0
    s_cbranch_scc1 K2_L0
    s_branch K2_M0
K2_R1:
    v_mul_f32 v176, v176, v130
    v_mul_f32 v180, v180, v134
    v_mul_f32 v184, v184, v138
    v_mul_f32 v188, v188, v142
    v_fmac_f32 v176, v177, v131
    v_fmac_f32 v180, v181, v135
    v_fmac_f32 v184, v185, v139
    v_fmac_f32 v188, v189, v143
    v_fmac_f32 v176, v178, v132
    v_fmac_f32 v180, v182, v136
    v_fmac_f32 v184, v186, v140
    v_fmac_f32 v188, v190, v144
    v_fmac_f32 v176, v179, v133
    v_fmac_f32 v180, v183, v137
    v_fmac_f32 v184, v187, v141
    v_fmac_f32 v188, v191, v145
    s_branch K2_C1
K2_R2:
    v_mul_f32 v192, v192, v130
    v_mul_f32 v196, v196, v134
    v_mul_f32 v200, v200, v138
    v_mul_f32 v204, v204, v142
    v_fmac_f32 v192, v193, v131
    v_fmac_f32 v196, v197, v135
    v_fmac_f32 v200, v201, v139
    v_fmac_f32 v204, v205, v143
    v_fmac_f32 v192, v194, v132
    v_fmac_f32 v196, v198, v136
    v_fmac_f32 v200, v202, v140
    v_fmac_f32 v204, v206, v144
    v_fmac_f32 v192, v195, v133
    v_fmac_f32 v196, v199, v137
    v_fmac_f32 v200, v203, v141
    v_fmac_f32 v204, v207, v145
    s_branch K2_C2
K2_R3:
    v_mul_f32 v208, v208, v130
    v_mul_f32 v212, v212, v134
    v_mul_f32 v216, v216, v138
    v_mul_f32 v220, v220, v142
    v_fmac_f32 v208, v209, v131
    v_fmac_f32 v212, v213, v135
    v_fmac_f32 v216, v217, v139
    v_fmac_f32 v220, v221, v143
    v_fmac_f32 v208, v210, v132
    v_fmac_f32 v212, v214, v136
    v_fmac_f32 v216, v218, v140
    v_fmac_f32 v220, v222, v144
    v_fmac_f32 v208, v211, v133
    v_fmac_f32 v212, v215, v137
    v_fmac_f32 v216, v219, v141
    v_fmac_f32 v220, v223, v145
    s_branch K2_C3
K2_EPI:
    v_mul_f32 v176, v176, v130
    v_mul_f32 v180, v180, v134
    v_mul_f32 v184, v184, v138
    v_mul_f32 v188, v188, v142
    v_fmac_f32 v176, v177, v131
    v_fmac_f32 v180, v181, v135
    v_fmac_f32 v184, v185, v139
    v_fmac_f32 v188, v189, v143
    v_fmac_f32 v176, v178, v132
    v_fmac_f32 v180, v182, v136
    v_fmac_f32 v184, v186, v140
    v_fmac_f32 v188, v190, v144
    v_fmac_f32 v176, v179, v133
    v_fmac_f32 v180, v183, v137
    v_fmac_f32 v184, v187, v141
    v_fmac_f32 v188, v191, v145
    v_mul_f32 v192, v192, v130
    v_mul_f32 v196, v196, v134
    v_mul_f32 v200, v200, v138
    v_mul_f32 v204, v204, v142
    v_fmac_f32 v192, v193, v131
    v_fmac_f32 v196, v197, v135
    v_fmac_f32 v200, v201, v139
    v_fmac_f32 v204, v205, v143
    v_fmac_f32 v192, v194, v132
    v_fmac_f32 v196, v198, v136
    v_fmac_f32 v200, v202, v140
    v_fmac_f32 v204, v206, v144
    v_fmac_f32 v192, v195, v133
    v_fmac_f32 v196, v199, v137
    v_fmac_f32 v200, v203, v141
    v_fmac_f32 v204, v207, v145
    v_mul_f32 v208, v208, v130
    v_mul_f32 v212, v212, v134
    v_mul_f32 v216, v216, v138
    v_mul_f32 v220, v220, v142
    v_fmac_f32 v208, v209, v131
    v_fmac_f32 v212, v213, v135
    v_fmac_f32 v216, v217, v139
    v_fmac_f32 v220, v221, v143
    v_fmac_f32 v208, v210, v132
    v_fmac_f32 v212, v214, v136
    v_fmac_f32 v216, v218, v140
    v_fmac_f32 v220, v222, v144
    v_fmac_f32 v208, v211, v133
    v_fmac_f32 v212, v215, v137
    v_fmac_f32 v216, v219, v141
    v_fmac_f32 v220, v223, v145
    s_branch K2_EPI3
K2_GOSLOW:
    s_max_u32 s61, s54, 32
    s_mov_b32 s58, 1
    s_mov_b32 s60, 1
    s_mov_b32 s48, 0
    s_waitcnt vmcnt(0) lgkmcnt(0)
    s_barrier
    s_branch K2_BATCH
K2_SLOWNEXT:
    s_waitcnt vmcnt(0) lgkmcnt(0)
    s_barrier
    s_add_u32 s60, s60, 1
    s_cmp_le_u32 s60, 2
    s_cbranch_scc1 K2_BATCH
    s_mov_b32 s60, 1
    s_add_u32 s59, s59, 1
    s_lshl_b32 s54, s59, 4
    s_cmp_lt_u32 s54, s61
    s_cbranch_scc1 K2_BATCH
    s_branch K2_EPI
K2_DONE:
    s_cmp_lg_u32 s58, 0
    s_cbranch_scc1 K2_SLOWNEXT
    s_cmp_lg_u32 s49, 2
    s_cbranch_scc1 K2_EPI
K2_EPI3:
    v_mul_f32 v224, v224, v130
    v_mul_f32 v228, v228, v134
    v_mul_f32 v232, v232, v138
    v_mul_f32 v236, v236, v142
    v_fmac_f32 v224, v225, v131
    v_fmac_f32 v228, v229, v135
    v_fmac_f32 v232, v233, v139
    v_fmac_f32 v236, v237, v143
    v_fmac_f32 v224, v226, v132
    v_fmac_f32 v228, v230, v136
    v_fmac_f32 v232, v234, v140
    v_fmac_f32 v236, v238, v144
    v_fmac_f32 v224, v227, v133
    v_fmac_f32 v228, v231, v137
    v_fmac_f32 v232, v235, v141
    v_fmac_f32 v236, v239, v145
    v_cvt_pk_bf16_f32 v50, v176, v192
    v_cvt_pk_bf16_f32 v51, v208, v224
    v_cvt_pk_bf16_f32 v52, v180, v196
    v_cvt_pk_bf16_f32 v53, v212, v228
    v_cvt_pk_bf16_f32 v54, v184, v200
    v_cvt_pk_bf16_f32 v55, v216, v232
    v_cvt_pk_bf16_f32 v56, v188, v204
    v_cvt_pk_bf16_f32 v57, v220, v236
    v_mfma_f32_16x16x16_bf16 v[176:179], v[50:51], v[162:163], 0
    v_mfma_f32_16x16x16_bf16 v[180:183], v[52:53], v[162:163], 0
    v_mfma_f32_16x16x16_bf16 v[184:187], v[54:55], v[162:163], 0
    v_mfma_f32_16x16x16_bf16 v[188:191], v[56:57], v[162:163], 0
    v_mul_f32 v240, v240, v130
    v_mul_f32 v244, v244, v134
    v_mul_f32 v248, v248, v138
    v_mul_f32 v252, v252, v142
    v_fmac_f32 v240, v241, v131
    v_fmac_f32 v244, v245, v135
    v_fmac_f32 v248, v249, v139
    v_cvt_pk_bf16_f32 v58, v176, v177
    v_cvt_pk_bf16_f32 v59, v178, v179
    v_cvt_pk_bf16_f32 v60, v180, v181
    v_cvt_pk_bf16_f32 v61, v182, v183
    v_cvt_pk_bf16_f32 v62, v184, v185
    v_cvt_pk_bf16_f32 v63, v186, v187
    v_cvt_pk_bf16_f32 v64, v188, v189
    v_cvt_pk_bf16_f32 v65, v190, v191
    v_mfma_f32_16x16x32_bf16 v[192:195], v[98:101], v[58:61], 0
    v_fmac_f32 v252, v253, v143
    v_mfma_f32_16x16x32_bf16 v[196:199], v[106:109], v[58:61], 0
    v_fmac_f32 v240, v242, v132
    v_mfma_f32_16x16x32_bf16 v[200:203], v[114:117], v[58:61], 0
    v_fmac_f32 v244, v246, v136
    v_mfma_f32_16x16x32_bf16 v[204:207], v[122:125], v[58:61], 0
    v_fmac_f32 v248, v250, v140
    v_mfma_f32_16x16x32_bf16 v[192:195], v[102:105], v[62:65], v[192:195]
    v_fmac_f32 v252, v254, v144
    v_mfma_f32_16x16x32_bf16 v[196:199], v[110:113], v[62:65], v[196:199]
    v_fmac_f32 v240, v243, v133
    v_mfma_f32_16x16x32_bf16 v[200:203], v[118:121], v[62:65], v[200:203]
    v_fmac_f32 v244, v247, v137
    v_mfma_f32_16x16x32_bf16 v[204:207], v[126:129], v[62:65], v[204:207]
    v_fmac_f32 v248, v251, v141
    v_fmac_f32 v252, v255, v145
    s_nop 5
    v_cvt_pk_bf16_f32 v66, v192, v193
    v_cvt_pk_bf16_f32 v67, v194, v195
    v_cvt_pk_bf16_f32 v68, v196, v197
    v_cvt_pk_bf16_f32 v69, v198, v199
    global_store_dwordx4 v47, v[66:69], s[20:21] offset:0 sc1
    v_cvt_pk_bf16_f32 v70, v200, v201
    v_cvt_pk_bf16_f32 v71, v202, v203
    v_cvt_pk_bf16_f32 v72, v204, v205
    v_cvt_pk_bf16_f32 v73, v206, v207
    global_store_dwordx4 v47, v[70:73], s[20:21] offset:64 sc1
    s_cmp_eq_u32 s86, 0
    s_cbranch_scc1 K2_FIN
    v_cvt_pk_bf16_f32 v50, v240, 0
    v_mov_b32 v51, 0
    v_cvt_pk_bf16_f32 v52, v244, 0
    v_mov_b32 v53, 0
    v_cvt_pk_bf16_f32 v54, v248, 0
    v_mov_b32 v55, 0
    v_cvt_pk_bf16_f32 v56, v252, 0
    v_mov_b32 v57, 0
    v_mfma_f32_16x16x16_bf16 v[176:179], v[50:51], v[162:163], 0
    v_mfma_f32_16x16x16_bf16 v[180:183], v[52:53], v[162:163], 0
    v_mfma_f32_16x16x16_bf16 v[184:187], v[54:55], v[162:163], 0
    v_mfma_f32_16x16x16_bf16 v[188:191], v[56:57], v[162:163], 0
    s_nop 6
    v_cvt_pk_bf16_f32 v58, v176, v177
    v_cvt_pk_bf16_f32 v59, v178, v179
    v_cvt_pk_bf16_f32 v60, v180, v181
    v_cvt_pk_bf16_f32 v61, v182, v183
    v_cvt_pk_bf16_f32 v62, v184, v185
    v_cvt_pk_bf16_f32 v63, v186, v187
    v_cvt_pk_bf16_f32 v64, v188, v189
    v_cvt_pk_bf16_f32 v65, v190, v191
    v_mfma_f32_16x16x32_bf16 v[192:195], v[98:101], v[58:61], 0
    v_mfma_f32_16x16x32_bf16 v[196:199], v[106:109], v[58:61], 0
    v_mfma_f32_16x16x32_bf16 v[200:203], v[114:117], v[58:61], 0
    v_mfma_f32_16x16x32_bf16 v[204:207], v[122:125], v[58:61], 0
    v_mfma_f32_16x16x32_bf16 v[192:195], v[102:105], v[62:65], v[192:195]
    v_mfma_f32_16x16x32_bf16 v[196:199], v[110:113], v[62:65], v[196:199]
    v_mfma_f32_16x16x32_bf16 v[200:203], v[118:121], v[62:65], v[200:203]
    v_mfma_f32_16x16x32_bf16 v[204:207], v[126:129], v[62:65], v[204:207]
    s_nop 6
    s_mov_b64 exec, s[86:87]
    v_cvt_pk_bf16_f32 v78, v192, v193
    v_cvt_pk_bf16_f32 v79, v194, v195
    v_cvt_pk_bf16_f32 v80, v196, v197
    v_cvt_pk_bf16_f32 v81, v198, v199
    global_store_dwordx4 v48, v[78:81], s[20:21] offset:0 sc1
    v_cvt_pk_bf16_f32 v82, v200, v201
    v_cvt_pk_bf16_f32 v83, v202, v203
    v_cvt_pk_bf16_f32 v84, v204, v205
    v_cvt_pk_bf16_f32 v85, v206, v207
    global_store_dwordx4 v48, v[82:85], s[20:21] offset:64 sc1
K2_FIN:
K_END:
    s_endpgm
.p2align 6
.type K_RANKTAB,@object
K_RANKTAB:
.byte 6, 12, 23, 30, 32, 63, 63, 63
.byte 2, 14, 25, 31, 34, 63, 63, 63
.byte 7, 17, 19, 26, 33, 63, 63, 63
.byte 4, 13, 18, 29, 36, 63, 63, 63
.byte 9, 11, 22, 27, 37, 63, 63, 63
.byte 10, 15, 20, 28, 35, 63, 63, 63
.byte 5, 16, 21, 24, 38, 63, 63, 63
.byte 0, 1, 3, 8, 39, 63, 63, 63
.byte 0, 13, 29, 30, 34, 63, 63, 63
.byte 1, 14, 18, 31, 33, 63, 63, 63
.byte 2, 12, 24, 27, 32, 63, 63, 63
.byte 7, 10, 15, 22, 35, 63, 63, 63
.byte 3, 16, 21, 26, 36, 63, 63, 63
.byte 6, 8, 19, 25, 38, 63, 63, 63
.byte 4, 11, 20, 28, 37, 63, 63, 63
.byte 5, 9, 17, 23, 39, 63, 63, 63
K_TABEND:
.section .rodata,"a"
.p2align 6
.amdhsa_kernel gather_scatter__tensor_product_equiv_mace__graph_kernel
  .amdhsa_next_free_vgpr 256
  .amdhsa_next_free_sgpr 102
  .amdhsa_accum_offset 256
  .amdhsa_group_segment_fixed_size 0
  .amdhsa_kernarg_size 88
  .amdhsa_user_sgpr_count 2
  .amdhsa_user_sgpr_kernarg_segment_ptr 1
  .amdhsa_system_sgpr_workgroup_id_x 1
  .amdhsa_float_denorm_mode_32 3
.end_amdhsa_kernel
```
